```python
import torch

def _softmax(x, axis=-1):
    return torch.softmax(x, dim=axis)
def _gelu(x):
    return torch.nn.functional.gelu(x, approximate="tanh")
def _silu(x):
    return torch.nn.functional.silu(x)
def _sigmoid(x):
    return torch.sigmoid(x)
def _layernorm(x, axis=-1, eps=1e-5):
    m = x.mean(dim=axis, keepdim=True)
    v = x.var(dim=axis, keepdim=True, unbiased=False)
    return (x - m) / torch.sqrt(v + eps)
def _scatter_add(tgt, idx, src, axis=0):
    return tgt.clone().index_add_(axis, idx, src)
def _segment_sum(src, seg, n):
    out = torch.zeros((n,) + src.shape[1:], dtype=src.dtype)
    return out.index_add_(0, seg, src)
def _pad(x, pw):
    flat = tuple(v for pair in reversed(pw) for v in pair)
    return torch.nn.functional.pad(x, flat)

kernel_name = 'standalone__low_rank_proj_linformer__prompt'

def setup_inputs():

    _w = (lambda a: (lambda t: t.to(torch.bfloat16) if t.is_floating_point() else t)(torch.as_tensor(a)))
    B, H, Sq, Skv, Dh, R = 1, 32, 2048, 2048, 128, 8
    return {
        "q": _w((lambda *s: torch.randn(*s, dtype=torch.bfloat16) * 0.8)(B, H, Sq, Dh)),
        "k": _w((lambda *s: torch.randn(*s, dtype=torch.bfloat16) * 0.8)(B, H, Skv, Dh)),
        "v": _w((lambda *s: torch.randn(*s, dtype=torch.bfloat16) * 0.05)(B, H, Skv, Dh)),
        "e_proj": _w((lambda *s: torch.randn(*s, dtype=torch.bfloat16) * 0.8)(R, Skv) * (Skv ** -0.5)),
        "f_proj": _w((lambda *s: torch.randn(*s, dtype=torch.bfloat16) * 0.05)(R, Skv) * (Skv ** -0.5)),
    }

def reference(q, k, v, e_proj, f_proj):
    B, H, Sq, Dh = q.shape
    kp = torch.einsum("rn,bhnd->bhrd", e_proj, k)
    vp = torch.einsum("rn,bhnd->bhrd", f_proj, v)
    scores = torch.einsum("bhqd,bhrd->bhqr", q, kp) * (Dh ** -0.5)
    p = _softmax(scores, axis=-1)
    o = torch.einsum("bhqr,bhrd->bhqd", p, vp)
    return o
```

```asm
; @launch grid=(256,1,1) block=(768,1,1) lds=73728
.amdgcn_target "amdgcn-amd-amdhsa--gfx950"
.text
.globl standalone__low_rank_proj_linformer__prompt_kernel
.p2align 8
.type standalone__low_rank_proj_linformer__prompt_kernel,@function
standalone__low_rank_proj_linformer__prompt_kernel:
    s_cmp_ge_u32 s2, 256
    s_cbranch_scc1 L_end
    s_load_dwordx16 s[4:19], s[0:1], 0
    v_and_b32 v1, 63, v0
    v_lshrrev_b32 v2, 4, v1
    v_and_b32 v3, 15, v1
    v_lshrrev_b32 v4, 6, v0
    s_and_b32 s21, s2, 31
    v_readfirstlane_b32 s20, v4
    s_lshr_b32 s22, s2, 5
    s_lshl_b32 s23, s21, 19
    v_lshlrev_b32 v10, 8, v3
    v_lshl_add_u32 v10, v2, 4, v10
    s_waitcnt lgkmcnt(0)
    s_cmp_ge_u32 s20, 8
    s_cbranch_scc1 L_qwave
    s_mov_b32 s28, s6
    s_and_b32 s29, s7, 0xffff
    s_mov_b32 s30, 0x1000000
    s_mov_b32 s31, 0x00020000
    s_mov_b32 s32, s8
    s_and_b32 s33, s9, 0xffff
    s_mov_b32 s34, 0x1000000
    s_mov_b32 s35, 0x00020000
    s_mov_b32 s36, s18
    s_and_b32 s37, s19, 0xffff
    s_mov_b32 s38, 0x200000
    s_mov_b32 s39, 0x00020000
    s_mov_b32 s40, s10
    s_and_b32 s41, s11, 0xffff
    s_mov_b32 s42, 0x8000
    s_mov_b32 s43, 0x00020000
    s_mov_b32 s44, s12
    s_and_b32 s45, s13, 0xffff
    s_mov_b32 s46, 0x8000
    s_mov_b32 s47, 0x00020000
    s_lshl_b32 s24, s20, 13
    s_add_u32 s23, s23, s24
    s_lshl_b32 s24, s20, 6
    v_and_b32 v5, 7, v3
    v_lshlrev_b32 v5, 12, v5
    v_lshl_add_u32 v5, v2, 3, v5
    v_mov_b32 v6, 0x80000000
    v_cmp_gt_u32 vcc, 8, v3
    s_mov_b32 s62, s22
    s_mov_b32 s63, 0
    v_cndmask_b32 v7, v6, v5, vcc
    v_cndmask_b32 v8, v5, v6, vcc
L_issue:
    s_lshl_b32 s25, s62, 16
    s_add_u32 s25, s25, s23
    s_add_u32 s26, s25, 4096
    s_lshl_b32 s27, s62, 9
    s_add_u32 s27, s27, s24
    buffer_load_dwordx4 v[32:35], v10, s[28:31], s25 offen offset:0
    buffer_load_dwordx4 v[36:39], v10, s[28:31], s25 offen offset:64
    buffer_load_dwordx4 v[40:43], v10, s[28:31], s25 offen offset:128
    buffer_load_dwordx4 v[44:47], v10, s[28:31], s25 offen offset:192
    buffer_load_dwordx4 v[48:51], v10, s[28:31], s26 offen offset:0
    buffer_load_dwordx4 v[52:55], v10, s[28:31], s26 offen offset:64
    buffer_load_dwordx4 v[56:59], v10, s[28:31], s26 offen offset:128
    buffer_load_dwordx4 v[60:63], v10, s[28:31], s26 offen offset:192
    buffer_load_dwordx2 v[16:17], v7, s[40:43], s27 offen
    buffer_load_dwordx2 v[18:19], v7, s[40:43], s27 offen offset:32
    buffer_load_dwordx2 v[20:21], v8, s[44:47], s27 offen
    buffer_load_dwordx2 v[22:23], v8, s[44:47], s27 offen offset:32
    buffer_load_dwordx4 v[64:67], v10, s[32:35], s25 offen offset:0
    buffer_load_dwordx4 v[68:71], v10, s[32:35], s25 offen offset:64
    buffer_load_dwordx4 v[72:75], v10, s[32:35], s25 offen offset:128
    buffer_load_dwordx4 v[76:79], v10, s[32:35], s25 offen offset:192
    buffer_load_dwordx4 v[80:83], v10, s[32:35], s26 offen offset:0
    buffer_load_dwordx4 v[84:87], v10, s[32:35], s26 offen offset:64
    buffer_load_dwordx4 v[88:91], v10, s[32:35], s26 offen offset:128
    buffer_load_dwordx4 v[92:95], v10, s[32:35], s26 offen offset:192
    s_cmp_lg_u32 s63, 0
    s_cbranch_scc1 L_compute
    v_lshlrev_b32 v6, 3, v2
    v_sub_u32 v6, v3, v6
    v_mov_b32 v11, 0x3f80
    v_mov_b32 v12, 0x3f800000
    v_cmp_eq_u32 vcc, 0, v6
    v_cmp_eq_u32 s[50:51], 1, v6
    s_nop 1
    v_cndmask_b32 v24, 0, v11, vcc
    v_cndmask_b32 v9, 0, v12, s[50:51]
    v_or_b32 v24, v24, v9
    v_cmp_eq_u32 vcc, 2, v6
    v_cmp_eq_u32 s[50:51], 3, v6
    s_nop 1
    v_cndmask_b32 v25, 0, v11, vcc
    v_cndmask_b32 v9, 0, v12, s[50:51]
    v_or_b32 v25, v25, v9
    v_cmp_eq_u32 vcc, 4, v6
    v_cmp_eq_u32 s[50:51], 5, v6
    s_nop 1
    v_cndmask_b32 v26, 0, v11, vcc
    v_cndmask_b32 v9, 0, v12, s[50:51]
    v_or_b32 v26, v26, v9
    v_cmp_eq_u32 vcc, 6, v6
    v_cmp_eq_u32 s[50:51], 7, v6
    s_nop 1
    v_cndmask_b32 v27, 0, v11, vcc
    v_cndmask_b32 v9, 0, v12, s[50:51]
    v_or_b32 v27, v27, v9
    v_cmp_eq_u32 vcc, -16, v6
    v_cmp_eq_u32 s[50:51], -15, v6
    s_nop 1
    v_cndmask_b32 v28, 0, v11, vcc
    v_cndmask_b32 v9, 0, v12, s[50:51]
    v_or_b32 v28, v28, v9
    v_cmp_eq_u32 vcc, -14, v6
    v_cmp_eq_u32 s[50:51], -13, v6
    s_nop 1
    v_cndmask_b32 v29, 0, v11, vcc
    v_cndmask_b32 v9, 0, v12, s[50:51]
    v_or_b32 v29, v29, v9
    v_cmp_eq_u32 vcc, -12, v6
    v_cmp_eq_u32 s[50:51], -11, v6
    s_nop 1
    v_cndmask_b32 v30, 0, v11, vcc
    v_cndmask_b32 v9, 0, v12, s[50:51]
    v_or_b32 v30, v30, v9
    v_cmp_eq_u32 vcc, -10, v6
    v_cmp_eq_u32 s[50:51], -9, v6
    s_nop 1
    v_cndmask_b32 v31, 0, v11, vcc
    v_cndmask_b32 v9, 0, v12, s[50:51]
    v_or_b32 v31, v31, v9
    v_mov_b32 v96, 0
    v_mov_b32 v97, 0
    v_mov_b32 v98, 0
    v_mov_b32 v99, 0
    v_mov_b32 v100, 0
    v_mov_b32 v101, 0
    v_mov_b32 v102, 0
    v_mov_b32 v103, 0
    v_mov_b32 v104, 0
    v_mov_b32 v105, 0
    v_mov_b32 v106, 0
    v_mov_b32 v107, 0
    v_mov_b32 v108, 0
    v_mov_b32 v109, 0
    v_mov_b32 v110, 0
    v_mov_b32 v111, 0
    v_mov_b32 v112, 0
    v_mov_b32 v113, 0
    v_mov_b32 v114, 0
    v_mov_b32 v115, 0
    v_mov_b32 v116, 0
    v_mov_b32 v117, 0
    v_mov_b32 v118, 0
    v_mov_b32 v119, 0
    v_mov_b32 v120, 0
    v_mov_b32 v121, 0
    v_mov_b32 v122, 0
    v_mov_b32 v123, 0
    v_mov_b32 v124, 0
    v_mov_b32 v125, 0
    v_mov_b32 v126, 0
    v_mov_b32 v127, 0
L_compute:
    s_waitcnt vmcnt(16)
    v_mfma_f32_16x16x32_bf16 v[128:131], v[32:35], v[24:27], 0
    v_mfma_f32_16x16x32_bf16 v[132:135], v[32:35], v[28:31], 0
    v_mfma_f32_16x16x32_bf16 v[136:139], v[36:39], v[24:27], 0
    v_mfma_f32_16x16x32_bf16 v[140:143], v[36:39], v[28:31], 0
    s_nop 7
    v_cvt_pk_bf16_f32 v144, v128, v129
    v_cvt_pk_bf16_f32 v145, v130, v131
    v_cvt_pk_bf16_f32 v146, v132, v133
    v_cvt_pk_bf16_f32 v147, v134, v135
    v_cvt_pk_bf16_f32 v148, v136, v137
    v_cvt_pk_bf16_f32 v149, v138, v139
    v_cvt_pk_bf16_f32 v150, v140, v141
    v_cvt_pk_bf16_f32 v151, v142, v143
    v_mfma_f32_16x16x32_bf16 v[128:131], v[40:43], v[24:27], 0
    v_mfma_f32_16x16x32_bf16 v[132:135], v[40:43], v[28:31], 0
    v_mfma_f32_16x16x32_bf16 v[136:139], v[44:47], v[24:27], 0
    v_mfma_f32_16x16x32_bf16 v[140:143], v[44:47], v[28:31], 0
    s_nop 7
    v_cvt_pk_bf16_f32 v152, v128, v129
    v_cvt_pk_bf16_f32 v153, v130, v131
    v_cvt_pk_bf16_f32 v154, v132, v133
    v_cvt_pk_bf16_f32 v155, v134, v135
    v_cvt_pk_bf16_f32 v156, v136, v137
    v_cvt_pk_bf16_f32 v157, v138, v139
    v_cvt_pk_bf16_f32 v158, v140, v141
    v_cvt_pk_bf16_f32 v159, v142, v143
    s_waitcnt vmcnt(8)
    s_nop 1
    v_mfma_f32_16x16x16_bf16 v[96:99], v[16:17], v[144:145], v[96:99]
    v_mfma_f32_16x16x16_bf16 v[100:103], v[16:17], v[146:147], v[100:103]
    v_mfma_f32_16x16x16_bf16 v[104:107], v[16:17], v[148:149], v[104:107]
    v_mfma_f32_16x16x16_bf16 v[108:111], v[16:17], v[150:151], v[108:111]
    v_mfma_f32_16x16x16_bf16 v[112:115], v[16:17], v[152:153], v[112:115]
    v_mfma_f32_16x16x16_bf16 v[116:119], v[16:17], v[154:155], v[116:119]
    v_mfma_f32_16x16x16_bf16 v[120:123], v[16:17], v[156:157], v[120:123]
    v_mfma_f32_16x16x16_bf16 v[124:127], v[16:17], v[158:159], v[124:127]
    s_waitcnt vmcnt(8)
    v_mfma_f32_16x16x32_bf16 v[128:131], v[48:51], v[24:27], 0
    v_mfma_f32_16x16x32_bf16 v[132:135], v[48:51], v[28:31], 0
    v_mfma_f32_16x16x32_bf16 v[136:139], v[52:55], v[24:27], 0
    v_mfma_f32_16x16x32_bf16 v[140:143], v[52:55], v[28:31], 0
    s_nop 7
    v_cvt_pk_bf16_f32 v144, v128, v129
    v_cvt_pk_bf16_f32 v145, v130, v131
    v_cvt_pk_bf16_f32 v146, v132, v133
    v_cvt_pk_bf16_f32 v147, v134, v135
    v_cvt_pk_bf16_f32 v148, v136, v137
    v_cvt_pk_bf16_f32 v149, v138, v139
    v_cvt_pk_bf16_f32 v150, v140, v141
    v_cvt_pk_bf16_f32 v151, v142, v143
    v_mfma_f32_16x16x32_bf16 v[128:131], v[56:59], v[24:27], 0
    v_mfma_f32_16x16x32_bf16 v[132:135], v[56:59], v[28:31], 0
    v_mfma_f32_16x16x32_bf16 v[136:139], v[60:63], v[24:27], 0
    v_mfma_f32_16x16x32_bf16 v[140:143], v[60:63], v[28:31], 0
    s_nop 7
    v_cvt_pk_bf16_f32 v152, v128, v129
    v_cvt_pk_bf16_f32 v153, v130, v131
    v_cvt_pk_bf16_f32 v154, v132, v133
    v_cvt_pk_bf16_f32 v155, v134, v135
    v_cvt_pk_bf16_f32 v156, v136, v137
    v_cvt_pk_bf16_f32 v157, v138, v139
    v_cvt_pk_bf16_f32 v158, v140, v141
    v_cvt_pk_bf16_f32 v159, v142, v143
    s_nop 1
    v_mfma_f32_16x16x16_bf16 v[96:99], v[18:19], v[144:145], v[96:99]
    v_mfma_f32_16x16x16_bf16 v[100:103], v[18:19], v[146:147], v[100:103]
    v_mfma_f32_16x16x16_bf16 v[104:107], v[18:19], v[148:149], v[104:107]
    v_mfma_f32_16x16x16_bf16 v[108:111], v[18:19], v[150:151], v[108:111]
    v_mfma_f32_16x16x16_bf16 v[112:115], v[18:19], v[152:153], v[112:115]
    v_mfma_f32_16x16x16_bf16 v[116:119], v[18:19], v[154:155], v[116:119]
    v_mfma_f32_16x16x16_bf16 v[120:123], v[18:19], v[156:157], v[120:123]
    v_mfma_f32_16x16x16_bf16 v[124:127], v[18:19], v[158:159], v[124:127]
    s_waitcnt vmcnt(4)
    v_mfma_f32_16x16x32_bf16 v[128:131], v[64:67], v[24:27], 0
    v_mfma_f32_16x16x32_bf16 v[132:135], v[64:67], v[28:31], 0
    v_mfma_f32_16x16x32_bf16 v[136:139], v[68:71], v[24:27], 0
    v_mfma_f32_16x16x32_bf16 v[140:143], v[68:71], v[28:31], 0
    s_nop 7
    v_cvt_pk_bf16_f32 v144, v128, v129
    v_cvt_pk_bf16_f32 v145, v130, v131
    v_cvt_pk_bf16_f32 v146, v132, v133
    v_cvt_pk_bf16_f32 v147, v134, v135
    v_cvt_pk_bf16_f32 v148, v136, v137
    v_cvt_pk_bf16_f32 v149, v138, v139
    v_cvt_pk_bf16_f32 v150, v140, v141
    v_cvt_pk_bf16_f32 v151, v142, v143
    v_mfma_f32_16x16x32_bf16 v[128:131], v[72:75], v[24:27], 0
    v_mfma_f32_16x16x32_bf16 v[132:135], v[72:75], v[28:31], 0
    v_mfma_f32_16x16x32_bf16 v[136:139], v[76:79], v[24:27], 0
    v_mfma_f32_16x16x32_bf16 v[140:143], v[76:79], v[28:31], 0
    s_nop 7
    v_cvt_pk_bf16_f32 v152, v128, v129
    v_cvt_pk_bf16_f32 v153, v130, v131
    v_cvt_pk_bf16_f32 v154, v132, v133
    v_cvt_pk_bf16_f32 v155, v134, v135
    v_cvt_pk_bf16_f32 v156, v136, v137
    v_cvt_pk_bf16_f32 v157, v138, v139
    v_cvt_pk_bf16_f32 v158, v140, v141
    v_cvt_pk_bf16_f32 v159, v142, v143
    s_nop 1
    v_mfma_f32_16x16x16_bf16 v[96:99], v[20:21], v[144:145], v[96:99]
    v_mfma_f32_16x16x16_bf16 v[100:103], v[20:21], v[146:147], v[100:103]
    v_mfma_f32_16x16x16_bf16 v[104:107], v[20:21], v[148:149], v[104:107]
    v_mfma_f32_16x16x16_bf16 v[108:111], v[20:21], v[150:151], v[108:111]
    v_mfma_f32_16x16x16_bf16 v[112:115], v[20:21], v[152:153], v[112:115]
    v_mfma_f32_16x16x16_bf16 v[116:119], v[20:21], v[154:155], v[116:119]
    v_mfma_f32_16x16x16_bf16 v[120:123], v[20:21], v[156:157], v[120:123]
    v_mfma_f32_16x16x16_bf16 v[124:127], v[20:21], v[158:159], v[124:127]
    s_waitcnt vmcnt(0)
    v_mfma_f32_16x16x32_bf16 v[128:131], v[80:83], v[24:27], 0
    v_mfma_f32_16x16x32_bf16 v[132:135], v[80:83], v[28:31], 0
    v_mfma_f32_16x16x32_bf16 v[136:139], v[84:87], v[24:27], 0
    v_mfma_f32_16x16x32_bf16 v[140:143], v[84:87], v[28:31], 0
    s_nop 7
    v_cvt_pk_bf16_f32 v144, v128, v129
    v_cvt_pk_bf16_f32 v145, v130, v131
    v_cvt_pk_bf16_f32 v146, v132, v133
    v_cvt_pk_bf16_f32 v147, v134, v135
    v_cvt_pk_bf16_f32 v148, v136, v137
    v_cvt_pk_bf16_f32 v149, v138, v139
    v_cvt_pk_bf16_f32 v150, v140, v141
    v_cvt_pk_bf16_f32 v151, v142, v143
    v_mfma_f32_16x16x32_bf16 v[128:131], v[88:91], v[24:27], 0
    v_mfma_f32_16x16x32_bf16 v[132:135], v[88:91], v[28:31], 0
    v_mfma_f32_16x16x32_bf16 v[136:139], v[92:95], v[24:27], 0
    v_mfma_f32_16x16x32_bf16 v[140:143], v[92:95], v[28:31], 0
    s_nop 7
    v_cvt_pk_bf16_f32 v152, v128, v129
    v_cvt_pk_bf16_f32 v153, v130, v131
    v_cvt_pk_bf16_f32 v154, v132, v133
    v_cvt_pk_bf16_f32 v155, v134, v135
    v_cvt_pk_bf16_f32 v156, v136, v137
    v_cvt_pk_bf16_f32 v157, v138, v139
    v_cvt_pk_bf16_f32 v158, v140, v141
    v_cvt_pk_bf16_f32 v159, v142, v143
    s_nop 1
    v_mfma_f32_16x16x16_bf16 v[96:99], v[22:23], v[144:145], v[96:99]
    v_mfma_f32_16x16x16_bf16 v[100:103], v[22:23], v[146:147], v[100:103]
    v_mfma_f32_16x16x16_bf16 v[104:107], v[22:23], v[148:149], v[104:107]
    v_mfma_f32_16x16x16_bf16 v[108:111], v[22:23], v[150:151], v[108:111]
    v_mfma_f32_16x16x16_bf16 v[112:115], v[22:23], v[152:153], v[112:115]
    v_mfma_f32_16x16x16_bf16 v[116:119], v[22:23], v[154:155], v[116:119]
    v_mfma_f32_16x16x16_bf16 v[120:123], v[22:23], v[156:157], v[120:123]
    v_mfma_f32_16x16x16_bf16 v[124:127], v[22:23], v[158:159], v[124:127]
    s_cmp_eq_u32 s63, 0
    s_cbranch_scc1 L_reduce
    s_cmp_eq_u32 s63, 7
    s_cbranch_scc1 L_reduce
    s_add_u32 s63, s63, 1
    s_add_u32 s62, s62, 1
    s_and_b32 s62, s62, 7
    s_branch L_issue
L_reduce:
    v_lshlrev_b32 v5, 4, v1
    v_add_u32 v5, 8192, v5
    s_lshl_b32 s48, s20, 13
    v_add_u32 v6, s48, v5
    s_nop 4
    ds_write_b128 v6, v[96:99] offset:0
    ds_write_b128 v6, v[100:103] offset:1024
    ds_write_b128 v6, v[104:107] offset:2048
    ds_write_b128 v6, v[108:111] offset:3072
    ds_write_b128 v6, v[112:115] offset:4096
    ds_write_b128 v6, v[116:119] offset:5120
    ds_write_b128 v6, v[120:123] offset:6144
    ds_write_b128 v6, v[124:127] offset:7168
    s_waitcnt lgkmcnt(0)
    s_barrier
    s_lshl_b32 s48, s20, 10
    v_add_u32 v6, s48, v5
    ds_read_b128 v[32:35], v6 offset:0
    ds_read_b128 v[36:39], v6 offset:8192
    ds_read_b128 v[40:43], v6 offset:16384
    ds_read_b128 v[44:47], v6 offset:24576
    ds_read_b128 v[48:51], v6 offset:32768
    ds_read_b128 v[52:55], v6 offset:40960
    ds_read_b128 v[56:59], v6 offset:49152
    ds_read_b128 v[60:63], v6 offset:57344
    v_lshlrev_b32 v7, 4, v0
    s_waitcnt lgkmcnt(6)
    v_add_f32 v32, v32, v36
    v_add_f32 v33, v33, v37
    v_add_f32 v34, v34, v38
    v_add_f32 v35, v35, v39
    s_waitcnt lgkmcnt(5)
    v_add_f32 v32, v32, v40
    v_add_f32 v33, v33, v41
    v_add_f32 v34, v34, v42
    v_add_f32 v35, v35, v43
    s_waitcnt lgkmcnt(4)
    v_add_f32 v32, v32, v44
    v_add_f32 v33, v33, v45
    v_add_f32 v34, v34, v46
    v_add_f32 v35, v35, v47
    s_waitcnt lgkmcnt(3)
    v_add_f32 v32, v32, v48
    v_add_f32 v33, v33, v49
    v_add_f32 v34, v34, v50
    v_add_f32 v35, v35, v51
    s_waitcnt lgkmcnt(2)
    v_add_f32 v32, v32, v52
    v_add_f32 v33, v33, v53
    v_add_f32 v34, v34, v54
    v_add_f32 v35, v35, v55
    s_waitcnt lgkmcnt(1)
    v_add_f32 v32, v32, v56
    v_add_f32 v33, v33, v57
    v_add_f32 v34, v34, v58
    v_add_f32 v35, v35, v59
    s_waitcnt lgkmcnt(0)
    v_add_f32 v32, v32, v60
    v_add_f32 v33, v33, v61
    v_add_f32 v34, v34, v62
    v_add_f32 v35, v35, v63
    s_cmp_lg_u32 s63, 0
    s_cbranch_scc1 L_final
    s_lshl_b32 s48, s21, 16
    s_lshl_b32 s49, s22, 13
    s_add_u32 s49, s49, s48
    buffer_store_dwordx4 v[32:35], v7, s[36:39], s49 offen
    s_waitcnt vmcnt(0)
    s_barrier
    s_cmp_lg_u32 s20, 0
    s_cbranch_scc1 L_nopoll
    s_getreg_b32 s52, hwreg(HW_REG_XCC_ID, 0, 4)
    s_add_u32 s52, s52, 1
    s_lshl_b32 s49, s21, 3
    v_mov_b32 v8, s49
    s_add_u32 s49, s49, s22
    v_mov_b32 v11, s49
    v_mov_b32 v9, s52
    s_mul_i32 s52, s52, 0x01010101
    s_mov_b64 exec, 1
    global_store_byte v11, v9, s[16:17]
    s_mov_b64 exec, -1
    s_mov_b32 s50, 0
    v_mov_b32 v14, 0
L_poll:
    global_load_dwordx2 v[12:13], v8, s[16:17] sc1
    s_waitcnt vmcnt(0)
    v_readfirstlane_b32 s54, v12
    v_readfirstlane_b32 s55, v13
    s_add_u32 s50, s50, 1
    s_xor_b32 s54, s54, s52
    s_xor_b32 s55, s55, s52
    s_or_b32 s54, s54, s55
    s_cmp_eq_u32 s54, 0
    s_cbranch_scc1 L_decided
    s_cmp_lt_u32 s50, 150
    s_cbranch_scc0 L_timeout
    s_sleep 1
    s_branch L_poll
L_timeout:
    v_mov_b32 v14, 1
L_decided:
    v_mov_b32 v15, 6144
    ds_write_b32 v15, v14
    s_waitcnt lgkmcnt(0)
L_nopoll:
    s_barrier
    v_mov_b32 v15, 6144
    ds_read_b32 v14, v15
    s_waitcnt lgkmcnt(0)
    v_readfirstlane_b32 s50, v14
    s_cmp_eq_u32 s50, 0
    s_cbranch_scc1 L_gather
    v_and_b32 v5, 7, v3
    v_lshlrev_b32 v5, 12, v5
    v_lshl_add_u32 v5, v2, 3, v5
    v_mov_b32 v6, 0x80000000
    v_cmp_gt_u32 vcc, 8, v3
    s_mov_b32 s63, 1
    s_add_u32 s62, s62, 1
    s_and_b32 s62, s62, 7
    v_cndmask_b32 v7, v6, v5, vcc
    v_cndmask_b32 v8, v5, v6, vcc
    s_branch L_issue
L_gather:
    s_add_u32 s49, s48, 0
    buffer_load_dwordx4 v[32:35], v7, s[36:39], s49 offen sc1
    s_add_u32 s49, s48, 8192
    buffer_load_dwordx4 v[36:39], v7, s[36:39], s49 offen sc1
    s_add_u32 s49, s48, 16384
    buffer_load_dwordx4 v[40:43], v7, s[36:39], s49 offen sc1
    s_add_u32 s49, s48, 24576
    buffer_load_dwordx4 v[44:47], v7, s[36:39], s49 offen sc1
    s_add_u32 s49, s48, 32768
    buffer_load_dwordx4 v[48:51], v7, s[36:39], s49 offen sc1
    s_add_u32 s49, s48, 40960
    buffer_load_dwordx4 v[52:55], v7, s[36:39], s49 offen sc1
    s_add_u32 s49, s48, 49152
    buffer_load_dwordx4 v[56:59], v7, s[36:39], s49 offen sc1
    s_add_u32 s49, s48, 57344
    buffer_load_dwordx4 v[60:63], v7, s[36:39], s49 offen sc1
    s_waitcnt vmcnt(6)
    v_add_f32 v32, v32, v36
    v_add_f32 v33, v33, v37
    v_add_f32 v34, v34, v38
    v_add_f32 v35, v35, v39
    s_waitcnt vmcnt(5)
    v_add_f32 v32, v32, v40
    v_add_f32 v33, v33, v41
    v_add_f32 v34, v34, v42
    v_add_f32 v35, v35, v43
    s_waitcnt vmcnt(4)
    v_add_f32 v32, v32, v44
    v_add_f32 v33, v33, v45
    v_add_f32 v34, v34, v46
    v_add_f32 v35, v35, v47
    s_waitcnt vmcnt(3)
    v_add_f32 v32, v32, v48
    v_add_f32 v33, v33, v49
    v_add_f32 v34, v34, v50
    v_add_f32 v35, v35, v51
    s_waitcnt vmcnt(2)
    v_add_f32 v32, v32, v52
    v_add_f32 v33, v33, v53
    v_add_f32 v34, v34, v54
    v_add_f32 v35, v35, v55
    s_waitcnt vmcnt(1)
    v_add_f32 v32, v32, v56
    v_add_f32 v33, v33, v57
    v_add_f32 v34, v34, v58
    v_add_f32 v35, v35, v59
    s_waitcnt vmcnt(0)
    v_add_f32 v32, v32, v60
    v_add_f32 v33, v33, v61
    v_add_f32 v34, v34, v62
    v_add_f32 v35, v35, v63
L_final:
    v_cvt_pk_bf16_f32 v36, v32, v33
    v_cvt_pk_bf16_f32 v37, v34, v35
    s_lshl_b32 s49, s20, 4
    v_add_u32 v8, s49, v3
    v_lshlrev_b32 v9, 10, v2
    v_lshl_add_u32 v9, v8, 1, v9
    v_and_b32 v11, 1, v2
    v_lshlrev_b32 v11, 3, v11
    v_lshl_add_u32 v11, v8, 4, v11
    s_mov_b32 exec_lo, -1
    s_mov_b32 exec_hi, 0
    ds_write_b16 v9, v36 offset:0
    ds_write_b16_d16_hi v9, v36 offset:256
    ds_write_b16 v9, v37 offset:512
    ds_write_b16_d16_hi v9, v37 offset:768
    s_mov_b32 exec_lo, 0
    s_mov_b32 exec_hi, -1
    ds_write_b64 v11, v[36:37] offset:4096
    s_mov_b64 exec, -1
    s_waitcnt lgkmcnt(0)
    s_barrier
    s_endpgm
L_qwave:
    s_mov_b32 s28, s4
    s_and_b32 s29, s5, 0xffff
    s_mov_b32 s30, 0x1000000
    s_mov_b32 s31, 0x00020000
    s_mov_b32 s32, s14
    s_and_b32 s33, s15, 0xffff
    s_mov_b32 s34, 0x1000000
    s_mov_b32 s35, 0x00020000
    s_lshl_b32 s24, s22, 16
    s_add_u32 s23, s23, s24
    s_sub_u32 s25, s20, 8
    s_lshl_b32 s25, s25, 14
    s_add_u32 s25, s25, s23
    s_add_u32 s26, s25, 0
    buffer_load_dwordx4 v[32:35], v10, s[28:31], s26 offen offset:0
    buffer_load_dwordx4 v[36:39], v10, s[28:31], s26 offen offset:64
    buffer_load_dwordx4 v[40:43], v10, s[28:31], s26 offen offset:128
    buffer_load_dwordx4 v[44:47], v10, s[28:31], s26 offen offset:192
    s_add_u32 s26, s25, 4096
    buffer_load_dwordx4 v[48:51], v10, s[28:31], s26 offen offset:0
    buffer_load_dwordx4 v[52:55], v10, s[28:31], s26 offen offset:64
    buffer_load_dwordx4 v[56:59], v10, s[28:31], s26 offen offset:128
    buffer_load_dwordx4 v[60:63], v10, s[28:31], s26 offen offset:192
    s_add_u32 s26, s25, 8192
    buffer_load_dwordx4 v[64:67], v10, s[28:31], s26 offen offset:0
    buffer_load_dwordx4 v[68:71], v10, s[28:31], s26 offen offset:64
    buffer_load_dwordx4 v[72:75], v10, s[28:31], s26 offen offset:128
    buffer_load_dwordx4 v[76:79], v10, s[28:31], s26 offen offset:192
    s_add_u32 s26, s25, 12288
    buffer_load_dwordx4 v[80:83], v10, s[28:31], s26 offen offset:0
    buffer_load_dwordx4 v[84:87], v10, s[28:31], s26 offen offset:64
    buffer_load_dwordx4 v[88:91], v10, s[28:31], s26 offen offset:128
    buffer_load_dwordx4 v[92:95], v10, s[28:31], s26 offen offset:192
    v_subrev_u32 v5, 512, v0
    v_lshlrev_b32 v5, 3, v5
    v_mov_b32 v6, 0
    v_mov_b32 v7, 0
    ds_write_b64 v5, v[6:7] offset:2048
    s_waitcnt lgkmcnt(0)
    s_barrier
    v_mov_b32 v5, v10
    v_lshrrev_b32 v6, 2, v3
    v_lshlrev_b32 v6, 3, v6
    v_and_b32 v7, 3, v3
    v_add_u32 v6, v6, v7
    v_lshlrev_b32 v6, 4, v6
    v_and_b32 v7, 1, v2
    v_lshl_add_u32 v6, v7, 3, v6
    v_cmp_gt_u32 vcc, 2, v2
    s_mov_b32 s50, 0x3db504f3
    s_mov_b32 s51, 0x3fb8aa3b
    s_mov_b32 s52, 0xffff0000
    v_mov_b32 v8, 6144
    s_barrier
    s_barrier
    ds_read_b32 v9, v8
    s_waitcnt lgkmcnt(0)
    v_readfirstlane_b32 s53, v9
    s_cmp_eq_u32 s53, 0
    s_cbranch_scc1 L_qfast
    s_barrier
L_qfast:
    s_barrier
    ds_read_b128 v[96:99], v5 offset:0
    ds_read_b128 v[100:103], v5 offset:64
    ds_read_b128 v[104:107], v5 offset:128
    ds_read_b128 v[108:111], v5 offset:192
    ds_read_b64 v[112:113], v6 offset:4096
    ds_read_b64 v[114:115], v6 offset:4160
    ds_read_b64 v[116:117], v6 offset:4608
    ds_read_b64 v[118:119], v6 offset:4672
    ds_read_b64 v[120:121], v6 offset:5120
    ds_read_b64 v[122:123], v6 offset:5184
    ds_read_b64 v[124:125], v6 offset:5632
    ds_read_b64 v[126:127], v6 offset:5696
    s_waitcnt lgkmcnt(0)
    v_cndmask_b32 v112, 0, v112, vcc
    v_cndmask_b32 v113, 0, v113, vcc
    v_cndmask_b32 v114, 0, v114, vcc
    v_cndmask_b32 v115, 0, v115, vcc
    v_cndmask_b32 v116, 0, v116, vcc
    v_cndmask_b32 v117, 0, v117, vcc
    v_cndmask_b32 v118, 0, v118, vcc
    v_cndmask_b32 v119, 0, v119, vcc
    v_cndmask_b32 v120, 0, v120, vcc
    v_cndmask_b32 v121, 0, v121, vcc
    v_cndmask_b32 v122, 0, v122, vcc
    v_cndmask_b32 v123, 0, v123, vcc
    v_cndmask_b32 v124, 0, v124, vcc
    v_cndmask_b32 v125, 0, v125, vcc
    v_cndmask_b32 v126, 0, v126, vcc
    v_cndmask_b32 v127, 0, v127, vcc
    s_waitcnt vmcnt(12)
    v_mfma_f32_16x16x32_bf16 v[12:15], v[96:99], v[32:35], 0
    v_mfma_f32_16x16x32_bf16 v[12:15], v[100:103], v[36:39], v[12:15]
    v_mfma_f32_16x16x32_bf16 v[12:15], v[104:107], v[40:43], v[12:15]
    v_mfma_f32_16x16x32_bf16 v[12:15], v[108:111], v[44:47], v[12:15]
    s_waitcnt vmcnt(8)
    v_mfma_f32_16x16x32_bf16 v[20:23], v[96:99], v[48:51], 0
    v_mfma_f32_16x16x32_bf16 v[20:23], v[100:103], v[52:55], v[20:23]
    v_mfma_f32_16x16x32_bf16 v[20:23], v[104:107], v[56:59], v[20:23]
    v_mfma_f32_16x16x32_bf16 v[20:23], v[108:111], v[60:63], v[20:23]
    s_nop 7
    v_cvt_pk_bf16_f32 v16, v12, v13
    v_cvt_pk_bf16_f32 v17, v14, v15
    v_lshlrev_b32 v12, 16, v16
    v_and_b32 v13, s52, v16
    v_lshlrev_b32 v14, 16, v17
    v_and_b32 v15, s52, v17
    v_cvt_pk_bf16_f32 v24, v20, v21
    v_cvt_pk_bf16_f32 v25, v22, v23
    v_lshlrev_b32 v20, 16, v24
    v_and_b32 v21, s52, v24
    v_lshlrev_b32 v22, 16, v25
    v_and_b32 v23, s52, v25
    v_mul_f32 v12, s50, v12
    v_mul_f32 v13, s50, v13
    v_mul_f32 v14, s50, v14
    v_mul_f32 v15, s50, v15
    v_mul_f32 v20, s50, v20
    v_mul_f32 v21, s50, v21
    v_mul_f32 v22, s50, v22
    v_mul_f32 v23, s50, v23
    v_cvt_pk_bf16_f32 v16, v12, v13
    v_cvt_pk_bf16_f32 v17, v14, v15
    v_lshlrev_b32 v12, 16, v16
    v_and_b32 v13, s52, v16
    v_lshlrev_b32 v14, 16, v17
    v_and_b32 v15, s52, v17
    v_cvt_pk_bf16_f32 v24, v20, v21
    v_cvt_pk_bf16_f32 v25, v22, v23
    v_lshlrev_b32 v20, 16, v24
    v_and_b32 v21, s52, v24
    v_lshlrev_b32 v22, 16, v25
    v_and_b32 v23, s52, v25
    v_max_f32 v16, v12, v13
    v_max3_f32 v16, v16, v14, v15
    v_mov_b32 v17, v16
    v_max_f32 v24, v20, v21
    v_max3_f32 v24, v24, v22, v23
    v_mov_b32 v25, v24
    s_nop 1
    v_permlane16_swap_b32 v16, v17
    v_permlane16_swap_b32 v24, v25
    v_max_f32 v16, v16, v17
    v_sub_f32 v12, v12, v16
    v_sub_f32 v13, v13, v16
    v_sub_f32 v14, v14, v16
    v_sub_f32 v15, v15, v16
    v_mul_f32 v12, s51, v12
    v_mul_f32 v13, s51, v13
    v_mul_f32 v14, s51, v14
    v_mul_f32 v15, s51, v15
    v_exp_f32 v12, v12
    v_exp_f32 v13, v13
    v_exp_f32 v14, v14
    v_exp_f32 v15, v15
    v_max_f32 v24, v24, v25
    v_sub_f32 v20, v20, v24
    v_sub_f32 v21, v21, v24
    v_sub_f32 v22, v22, v24
    v_sub_f32 v23, v23, v24
    v_mul_f32 v20, s51, v20
    v_mul_f32 v21, s51, v21
    v_mul_f32 v22, s51, v22
    v_mul_f32 v23, s51, v23
    v_exp_f32 v20, v20
    v_exp_f32 v21, v21
    v_exp_f32 v22, v22
    v_exp_f32 v23, v23
    v_add_f32 v16, v12, v13
    v_add_f32 v17, v14, v15
    v_add_f32 v16, v16, v17
    v_mov_b32 v17, v16
    v_add_f32 v24, v20, v21
    v_add_f32 v25, v22, v23
    v_add_f32 v24, v24, v25
    v_mov_b32 v25, v24
    s_nop 1
    v_permlane16_swap_b32 v16, v17
    v_permlane16_swap_b32 v24, v25
    v_add_f32 v16, v16, v17
    v_rcp_f32 v16, v16
    v_add_f32 v24, v24, v25
    v_rcp_f32 v24, v24
    v_mul_f32 v12, v12, v16
    v_mul_f32 v13, v13, v16
    v_mul_f32 v14, v14, v16
    v_mul_f32 v15, v15, v16
    v_cvt_pk_bf16_f32 v18, v12, v13
    v_cvt_pk_bf16_f32 v19, v14, v15
    v_mul_f32 v20, v20, v24
    v_mul_f32 v21, v21, v24
    v_mul_f32 v22, v22, v24
    v_mul_f32 v23, v23, v24
    v_cvt_pk_bf16_f32 v26, v20, v21
    v_cvt_pk_bf16_f32 v27, v22, v23
    s_nop 1
    v_mfma_f32_16x16x16_bf16 v[128:131], v[112:113], v[18:19], 0
    v_mfma_f32_16x16x16_bf16 v[132:135], v[114:115], v[18:19], 0
    v_mfma_f32_16x16x16_bf16 v[136:139], v[116:117], v[18:19], 0
    v_mfma_f32_16x16x16_bf16 v[140:143], v[118:119], v[18:19], 0
    v_mfma_f32_16x16x16_bf16 v[144:147], v[120:121], v[18:19], 0
    v_mfma_f32_16x16x16_bf16 v[148:151], v[122:123], v[18:19], 0
    v_mfma_f32_16x16x16_bf16 v[152:155], v[124:125], v[18:19], 0
    v_mfma_f32_16x16x16_bf16 v[156:159], v[126:127], v[18:19], 0
    s_add_u32 s26, s25, 0
    s_nop 6
    v_cvt_pk_bf16_f32 v32, v128, v129
    v_cvt_pk_bf16_f32 v33, v130, v131
    v_cvt_pk_bf16_f32 v34, v132, v133
    v_cvt_pk_bf16_f32 v35, v134, v135
    buffer_store_dwordx4 v[32:35], v10, s[32:35], s26 offen offset:0
    v_cvt_pk_bf16_f32 v36, v136, v137
    v_cvt_pk_bf16_f32 v37, v138, v139
    v_cvt_pk_bf16_f32 v38, v140, v141
    v_cvt_pk_bf16_f32 v39, v142, v143
    buffer_store_dwordx4 v[36:39], v10, s[32:35], s26 offen offset:64
    v_cvt_pk_bf16_f32 v40, v144, v145
    v_cvt_pk_bf16_f32 v41, v146, v147
    v_cvt_pk_bf16_f32 v42, v148, v149
    v_cvt_pk_bf16_f32 v43, v150, v151
    buffer_store_dwordx4 v[40:43], v10, s[32:35], s26 offen offset:128
    v_cvt_pk_bf16_f32 v44, v152, v153
    v_cvt_pk_bf16_f32 v45, v154, v155
    v_cvt_pk_bf16_f32 v46, v156, v157
    v_cvt_pk_bf16_f32 v47, v158, v159
    buffer_store_dwordx4 v[44:47], v10, s[32:35], s26 offen offset:192
    v_mfma_f32_16x16x16_bf16 v[128:131], v[112:113], v[26:27], 0
    v_mfma_f32_16x16x16_bf16 v[132:135], v[114:115], v[26:27], 0
    v_mfma_f32_16x16x16_bf16 v[136:139], v[116:117], v[26:27], 0
    v_mfma_f32_16x16x16_bf16 v[140:143], v[118:119], v[26:27], 0
    v_mfma_f32_16x16x16_bf16 v[144:147], v[120:121], v[26:27], 0
    v_mfma_f32_16x16x16_bf16 v[148:151], v[122:123], v[26:27], 0
    v_mfma_f32_16x16x16_bf16 v[152:155], v[124:125], v[26:27], 0
    v_mfma_f32_16x16x16_bf16 v[156:159], v[126:127], v[26:27], 0
    s_add_u32 s26, s25, 4096
    s_nop 6
    v_cvt_pk_bf16_f32 v48, v128, v129
    v_cvt_pk_bf16_f32 v49, v130, v131
    v_cvt_pk_bf16_f32 v50, v132, v133
    v_cvt_pk_bf16_f32 v51, v134, v135
    buffer_store_dwordx4 v[48:51], v10, s[32:35], s26 offen offset:0
    v_cvt_pk_bf16_f32 v52, v136, v137
    v_cvt_pk_bf16_f32 v53, v138, v139
    v_cvt_pk_bf16_f32 v54, v140, v141
    v_cvt_pk_bf16_f32 v55, v142, v143
    buffer_store_dwordx4 v[52:55], v10, s[32:35], s26 offen offset:64
    v_cvt_pk_bf16_f32 v56, v144, v145
    v_cvt_pk_bf16_f32 v57, v146, v147
    v_cvt_pk_bf16_f32 v58, v148, v149
    v_cvt_pk_bf16_f32 v59, v150, v151
    buffer_store_dwordx4 v[56:59], v10, s[32:35], s26 offen offset:128
    v_cvt_pk_bf16_f32 v60, v152, v153
    v_cvt_pk_bf16_f32 v61, v154, v155
    v_cvt_pk_bf16_f32 v62, v156, v157
    v_cvt_pk_bf16_f32 v63, v158, v159
    buffer_store_dwordx4 v[60:63], v10, s[32:35], s26 offen offset:192
    s_waitcnt vmcnt(12)
    v_mfma_f32_16x16x32_bf16 v[12:15], v[96:99], v[64:67], 0
    v_mfma_f32_16x16x32_bf16 v[12:15], v[100:103], v[68:71], v[12:15]
    v_mfma_f32_16x16x32_bf16 v[12:15], v[104:107], v[72:75], v[12:15]
    v_mfma_f32_16x16x32_bf16 v[12:15], v[108:111], v[76:79], v[12:15]
    s_waitcnt vmcnt(8)
    v_mfma_f32_16x16x32_bf16 v[20:23], v[96:99], v[80:83], 0
    v_mfma_f32_16x16x32_bf16 v[20:23], v[100:103], v[84:87], v[20:23]
    v_mfma_f32_16x16x32_bf16 v[20:23], v[104:107], v[88:91], v[20:23]
    v_mfma_f32_16x16x32_bf16 v[20:23], v[108:111], v[92:95], v[20:23]
    s_nop 7
    v_cvt_pk_bf16_f32 v16, v12, v13
    v_cvt_pk_bf16_f32 v17, v14, v15
    v_lshlrev_b32 v12, 16, v16
    v_and_b32 v13, s52, v16
    v_lshlrev_b32 v14, 16, v17
    v_and_b32 v15, s52, v17
    v_cvt_pk_bf16_f32 v24, v20, v21
    v_cvt_pk_bf16_f32 v25, v22, v23
    v_lshlrev_b32 v20, 16, v24
    v_and_b32 v21, s52, v24
    v_lshlrev_b32 v22, 16, v25
    v_and_b32 v23, s52, v25
    v_mul_f32 v12, s50, v12
    v_mul_f32 v13, s50, v13
    v_mul_f32 v14, s50, v14
    v_mul_f32 v15, s50, v15
    v_mul_f32 v20, s50, v20
    v_mul_f32 v21, s50, v21
    v_mul_f32 v22, s50, v22
    v_mul_f32 v23, s50, v23
    v_cvt_pk_bf16_f32 v16, v12, v13
    v_cvt_pk_bf16_f32 v17, v14, v15
    v_lshlrev_b32 v12, 16, v16
    v_and_b32 v13, s52, v16
    v_lshlrev_b32 v14, 16, v17
    v_and_b32 v15, s52, v17
    v_cvt_pk_bf16_f32 v24, v20, v21
    v_cvt_pk_bf16_f32 v25, v22, v23
    v_lshlrev_b32 v20, 16, v24
    v_and_b32 v21, s52, v24
    v_lshlrev_b32 v22, 16, v25
    v_and_b32 v23, s52, v25
    v_max_f32 v16, v12, v13
    v_max3_f32 v16, v16, v14, v15
    v_mov_b32 v17, v16
    v_max_f32 v24, v20, v21
    v_max3_f32 v24, v24, v22, v23
    v_mov_b32 v25, v24
    s_nop 1
    v_permlane16_swap_b32 v16, v17
    v_permlane16_swap_b32 v24, v25
    v_max_f32 v16, v16, v17
    v_sub_f32 v12, v12, v16
    v_sub_f32 v13, v13, v16
    v_sub_f32 v14, v14, v16
    v_sub_f32 v15, v15, v16
    v_mul_f32 v12, s51, v12
    v_mul_f32 v13, s51, v13
    v_mul_f32 v14, s51, v14
    v_mul_f32 v15, s51, v15
    v_exp_f32 v12, v12
    v_exp_f32 v13, v13
    v_exp_f32 v14, v14
    v_exp_f32 v15, v15
    v_max_f32 v24, v24, v25
    v_sub_f32 v20, v20, v24
    v_sub_f32 v21, v21, v24
    v_sub_f32 v22, v22, v24
    v_sub_f32 v23, v23, v24
    v_mul_f32 v20, s51, v20
    v_mul_f32 v21, s51, v21
    v_mul_f32 v22, s51, v22
    v_mul_f32 v23, s51, v23
    v_exp_f32 v20, v20
    v_exp_f32 v21, v21
    v_exp_f32 v22, v22
    v_exp_f32 v23, v23
    v_add_f32 v16, v12, v13
    v_add_f32 v17, v14, v15
    v_add_f32 v16, v16, v17
    v_mov_b32 v17, v16
    v_add_f32 v24, v20, v21
    v_add_f32 v25, v22, v23
    v_add_f32 v24, v24, v25
    v_mov_b32 v25, v24
    s_nop 1
    v_permlane16_swap_b32 v16, v17
    v_permlane16_swap_b32 v24, v25
    v_add_f32 v16, v16, v17
    v_rcp_f32 v16, v16
    v_add_f32 v24, v24, v25
    v_rcp_f32 v24, v24
    v_mul_f32 v12, v12, v16
    v_mul_f32 v13, v13, v16
    v_mul_f32 v14, v14, v16
    v_mul_f32 v15, v15, v16
    v_cvt_pk_bf16_f32 v18, v12, v13
    v_cvt_pk_bf16_f32 v19, v14, v15
    v_mul_f32 v20, v20, v24
    v_mul_f32 v21, v21, v24
    v_mul_f32 v22, v22, v24
    v_mul_f32 v23, v23, v24
    v_cvt_pk_bf16_f32 v26, v20, v21
    v_cvt_pk_bf16_f32 v27, v22, v23
    s_nop 1
    v_mfma_f32_16x16x16_bf16 v[128:131], v[112:113], v[18:19], 0
    v_mfma_f32_16x16x16_bf16 v[132:135], v[114:115], v[18:19], 0
    v_mfma_f32_16x16x16_bf16 v[136:139], v[116:117], v[18:19], 0
    v_mfma_f32_16x16x16_bf16 v[140:143], v[118:119], v[18:19], 0
    v_mfma_f32_16x16x16_bf16 v[144:147], v[120:121], v[18:19], 0
    v_mfma_f32_16x16x16_bf16 v[148:151], v[122:123], v[18:19], 0
    v_mfma_f32_16x16x16_bf16 v[152:155], v[124:125], v[18:19], 0
    v_mfma_f32_16x16x16_bf16 v[156:159], v[126:127], v[18:19], 0
    s_add_u32 s26, s25, 8192
    s_nop 6
    v_cvt_pk_bf16_f32 v64, v128, v129
    v_cvt_pk_bf16_f32 v65, v130, v131
    v_cvt_pk_bf16_f32 v66, v132, v133
    v_cvt_pk_bf16_f32 v67, v134, v135
    buffer_store_dwordx4 v[64:67], v10, s[32:35], s26 offen offset:0
    v_cvt_pk_bf16_f32 v68, v136, v137
    v_cvt_pk_bf16_f32 v69, v138, v139
    v_cvt_pk_bf16_f32 v70, v140, v141
    v_cvt_pk_bf16_f32 v71, v142, v143
    buffer_store_dwordx4 v[68:71], v10, s[32:35], s26 offen offset:64
    v_cvt_pk_bf16_f32 v72, v144, v145
    v_cvt_pk_bf16_f32 v73, v146, v147
    v_cvt_pk_bf16_f32 v74, v148, v149
    v_cvt_pk_bf16_f32 v75, v150, v151
    buffer_store_dwordx4 v[72:75], v10, s[32:35], s26 offen offset:128
    v_cvt_pk_bf16_f32 v76, v152, v153
    v_cvt_pk_bf16_f32 v77, v154, v155
    v_cvt_pk_bf16_f32 v78, v156, v157
    v_cvt_pk_bf16_f32 v79, v158, v159
    buffer_store_dwordx4 v[76:79], v10, s[32:35], s26 offen offset:192
    v_mfma_f32_16x16x16_bf16 v[128:131], v[112:113], v[26:27], 0
    v_mfma_f32_16x16x16_bf16 v[132:135], v[114:115], v[26:27], 0
    v_mfma_f32_16x16x16_bf16 v[136:139], v[116:117], v[26:27], 0
    v_mfma_f32_16x16x16_bf16 v[140:143], v[118:119], v[26:27], 0
    v_mfma_f32_16x16x16_bf16 v[144:147], v[120:121], v[26:27], 0
    v_mfma_f32_16x16x16_bf16 v[148:151], v[122:123], v[26:27], 0
    v_mfma_f32_16x16x16_bf16 v[152:155], v[124:125], v[26:27], 0
    v_mfma_f32_16x16x16_bf16 v[156:159], v[126:127], v[26:27], 0
    s_add_u32 s26, s25, 12288
    s_nop 6
    v_cvt_pk_bf16_f32 v80, v128, v129
    v_cvt_pk_bf16_f32 v81, v130, v131
    v_cvt_pk_bf16_f32 v82, v132, v133
    v_cvt_pk_bf16_f32 v83, v134, v135
    buffer_store_dwordx4 v[80:83], v10, s[32:35], s26 offen offset:0
    v_cvt_pk_bf16_f32 v84, v136, v137
    v_cvt_pk_bf16_f32 v85, v138, v139
    v_cvt_pk_bf16_f32 v86, v140, v141
    v_cvt_pk_bf16_f32 v87, v142, v143
    buffer_store_dwordx4 v[84:87], v10, s[32:35], s26 offen offset:64
    v_cvt_pk_bf16_f32 v88, v144, v145
    v_cvt_pk_bf16_f32 v89, v146, v147
    v_cvt_pk_bf16_f32 v90, v148, v149
    v_cvt_pk_bf16_f32 v91, v150, v151
    buffer_store_dwordx4 v[88:91], v10, s[32:35], s26 offen offset:128
    v_cvt_pk_bf16_f32 v92, v152, v153
    v_cvt_pk_bf16_f32 v93, v154, v155
    v_cvt_pk_bf16_f32 v94, v156, v157
    v_cvt_pk_bf16_f32 v95, v158, v159
    buffer_store_dwordx4 v[92:95], v10, s[32:35], s26 offen offset:192
L_end:
    s_endpgm
.section .rodata,"a"
.p2align 6
.amdhsa_kernel standalone__low_rank_proj_linformer__prompt_kernel
  .amdhsa_next_free_vgpr 168
  .amdhsa_next_free_sgpr 72
  .amdhsa_accum_offset 168
  .amdhsa_group_segment_fixed_size 0
  .amdhsa_kernarg_size 64
  .amdhsa_user_sgpr_count 2
  .amdhsa_user_sgpr_kernarg_segment_ptr 1
  .amdhsa_system_sgpr_workgroup_id_x 1
.end_amdhsa_kernel
```
